```python
import torch

def _softmax(x, axis=-1):
    return torch.softmax(x, dim=axis)
def _gelu(x):
    return torch.nn.functional.gelu(x, approximate="tanh")
def _silu(x):
    return torch.nn.functional.silu(x)
def _sigmoid(x):
    return torch.sigmoid(x)
def _layernorm(x, axis=-1, eps=1e-5):
    m = x.mean(dim=axis, keepdim=True)
    v = x.var(dim=axis, keepdim=True, unbiased=False)
    return (x - m) / torch.sqrt(v + eps)
def _scatter_add(tgt, idx, src, axis=0):
    return tgt.clone().index_add_(axis, idx, src)
def _segment_sum(src, seg, n):
    out = torch.zeros((n,) + src.shape[1:], dtype=src.dtype)
    return out.index_add_(0, seg, src)
def _pad(x, pw):
    flat = tuple(v for pair in reversed(pw) for v in pair)
    return torch.nn.functional.pad(x, flat)

kernel_name = 'standalone__linear_kernel_rfa__decode'

def setup_inputs():

    _w = (lambda a: (lambda t: t.to(torch.bfloat16) if t.is_floating_point() else t)(torch.as_tensor(a)))
    B, H, Sq, Sk, D, M = 1, 32, 1, 32768, 128, 8
    return {
        "q": _w((lambda *s: torch.randn(*s, dtype=torch.bfloat16) * 0.05)(B, H, Sq, D)),
        "k": _w((lambda *s: torch.randn(*s, dtype=torch.bfloat16) * 0.4)(B, H, Sk, D)),
        "v": _w((lambda *s: torch.randn(*s, dtype=torch.bfloat16) * 0.4)(B, H, Sk, D)),
        "omega": _w((lambda *s: torch.randn(*s, dtype=torch.bfloat16) * 0.8)(M, D)),
    }

def reference(q, k, v, omega):
    d = q.shape[-1]
    m = omega.shape[0]
    scale = float(d) ** -0.25
    qs = q * scale
    ks = k * scale
    q_proj = torch.einsum("bhsd,md->bhsm", qs, omega)
    k_proj = torch.einsum("bhsd,md->bhsm", ks, omega)
    q_sq = 0.5 * torch.einsum("bhsd,bhsd->bhs", qs, qs)[..., None]
    k_sq = 0.5 * torch.einsum("bhsd,bhsd->bhs", ks, ks)[..., None]
    inv_sqrt_m = float(m) ** -0.5
    phi_q = torch.exp(q_proj - q_sq) * inv_sqrt_m + 1e-6
    phi_k = torch.exp(k_proj - k_sq) * inv_sqrt_m + 1e-6
    kv = torch.einsum("bhsm,bhsd->bhmd", phi_k, v)
    z  = torch.einsum("bhsm->bhm", phi_k)
    num = torch.einsum("bhqm,bhmd->bhqd", phi_q, kv)
    den = torch.einsum("bhqm,bhm->bhq", phi_q, z)[..., None] + 1e-6
    return num / den
```

```asm
; @launch grid=(256,1,1) block=(192,1,1) lds=110656
.amdgcn_target "amdgcn-amd-amdhsa--gfx950"
.text
.globl standalone__linear_kernel_rfa__decode_kernel
.p2align 8
.type standalone__linear_kernel_rfa__decode_kernel,@function
standalone__linear_kernel_rfa__decode_kernel:
  s_cmp_ge_u32 s2, 256
  s_cbranch_scc1 standalone__linear_kernel_rfa__decode_kernel_done
  s_load_dwordx8 s[4:11], s[0:1], 0
  s_cmp_ge_u32 s2, 16
  s_cbranch_scc1 standalone__linear_kernel_rfa__decode_kernel_npf
  s_getpc_b64 s[18:19]
standalone__linear_kernel_rfa__decode_kernel_pc:
  v_lshlrev_b32 v9, 6, v0
  v_min_u32 v9, standalone__linear_kernel_rfa__decode_kernel_codeend-standalone__linear_kernel_rfa__decode_kernel_pc-4, v9
  global_load_dword v31, v9, s[18:19]
standalone__linear_kernel_rfa__decode_kernel_npf:
  v_lshrrev_b32 v10, 6, v0
  s_bfe_u32 s35, s2, 0x10001
  s_bfe_u32 s43, s2, 0x40003
  s_lshl_b32 s43, s43, 1
  s_or_b32 s35, s35, s43
  v_readfirstlane_b32 s3, v10
  s_bfe_u32 s36, s2, 0x10000
  s_bfe_u32 s43, s2, 0x10002
  s_lshl_b32 s43, s43, 1
  s_or_b32 s36, s36, s43
  s_bfe_u32 s43, s2, 0x10007
  s_lshl_b32 s43, s43, 2
  s_or_b32 s36, s36, s43
  v_and_b32 v0, 63, v0
  s_cmp_lg_u32 s3, 0
  s_cbranch_scc1 standalone__linear_kernel_rfa__decode_kernel_consumer
  v_lshrrev_b32 v10, 4, v0
  v_and_b32 v8, 15, v0
  v_lshlrev_b32 v9, 2, v10
  v_xor_b32 v8, v8, v9
  v_lshlrev_b32 v10, 8, v10
  v_xor_b32 v9, 0, v8
  v_lshl_or_b32 v1, v9, 4, v10
  v_xor_b32 v9, 1, v8
  v_lshl_or_b32 v2, v9, 4, v10
  v_xor_b32 v9, 2, v8
  v_lshl_or_b32 v3, v9, 4, v10
  v_xor_b32 v9, 3, v8
  v_lshl_or_b32 v4, v9, 4, v10
  s_mul_i32 s57, s35, 16
  s_mov_b32 s56, s36
  s_lshl_b32 s43, s35, 23
  s_mov_b32 s22, 0x800000
  s_mov_b32 s23, 0x20000
  s_mov_b32 s58, 0
  s_waitcnt lgkmcnt(0)
  s_add_u32 s20, s6, s43
  s_addc_u32 s21, s7, 0
  s_and_b32 s21, s21, 0xffff
  s_add_u32 s32, s56, s57
  s_and_b32 s32, s32, 511
  s_lshl_b32 s32, s32, 14
  s_mov_b32 m0, s58
  s_add_u32 s58, s58, 4096
  buffer_load_dwordx4 v1, s[20:23], s32 offen offset:0 nt lds
  buffer_load_dwordx4 v2, s[20:23], s32 offen offset:1024 nt lds
  buffer_load_dwordx4 v3, s[20:23], s32 offen offset:2048 nt lds
  buffer_load_dwordx4 v4, s[20:23], s32 offen offset:3072 nt lds
  s_add_u32 s32, s32, 4096
  s_mov_b32 m0, s58
  s_add_u32 s58, s58, 4096
  buffer_load_dwordx4 v1, s[20:23], s32 offen offset:0 nt lds
  buffer_load_dwordx4 v2, s[20:23], s32 offen offset:1024 nt lds
  buffer_load_dwordx4 v3, s[20:23], s32 offen offset:2048 nt lds
  buffer_load_dwordx4 v4, s[20:23], s32 offen offset:3072 nt lds
  s_add_u32 s32, s32, 4096
  s_mov_b32 m0, s58
  s_add_u32 s58, s58, 4096
  buffer_load_dwordx4 v1, s[20:23], s32 offen offset:0 nt lds
  buffer_load_dwordx4 v2, s[20:23], s32 offen offset:1024 nt lds
  buffer_load_dwordx4 v3, s[20:23], s32 offen offset:2048 nt lds
  buffer_load_dwordx4 v4, s[20:23], s32 offen offset:3072 nt lds
  s_add_u32 s32, s32, 4096
  s_mov_b32 m0, s58
  s_add_u32 s58, s58, 4096
  buffer_load_dwordx4 v1, s[20:23], s32 offen offset:0 nt lds
  buffer_load_dwordx4 v2, s[20:23], s32 offen offset:1024 nt lds
  buffer_load_dwordx4 v3, s[20:23], s32 offen offset:2048 nt lds
  buffer_load_dwordx4 v4, s[20:23], s32 offen offset:3072 nt lds
  s_cmp_eq_u32 s58, 49152
  s_cselect_b32 s58, 0, s58
  s_add_u32 s56, s56, 8
  s_add_u32 s32, s56, s57
  s_and_b32 s32, s32, 511
  s_lshl_b32 s32, s32, 14
  s_mov_b32 m0, s58
  s_add_u32 s58, s58, 4096
  buffer_load_dwordx4 v1, s[20:23], s32 offen offset:0 nt lds
  buffer_load_dwordx4 v2, s[20:23], s32 offen offset:1024 nt lds
  buffer_load_dwordx4 v3, s[20:23], s32 offen offset:2048 nt lds
  buffer_load_dwordx4 v4, s[20:23], s32 offen offset:3072 nt lds
  s_add_u32 s32, s32, 4096
  s_mov_b32 m0, s58
  s_add_u32 s58, s58, 4096
  buffer_load_dwordx4 v1, s[20:23], s32 offen offset:0 nt lds
  buffer_load_dwordx4 v2, s[20:23], s32 offen offset:1024 nt lds
  buffer_load_dwordx4 v3, s[20:23], s32 offen offset:2048 nt lds
  buffer_load_dwordx4 v4, s[20:23], s32 offen offset:3072 nt lds
  s_add_u32 s32, s32, 4096
  s_mov_b32 m0, s58
  s_add_u32 s58, s58, 4096
  buffer_load_dwordx4 v1, s[20:23], s32 offen offset:0 nt lds
  buffer_load_dwordx4 v2, s[20:23], s32 offen offset:1024 nt lds
  buffer_load_dwordx4 v3, s[20:23], s32 offen offset:2048 nt lds
  buffer_load_dwordx4 v4, s[20:23], s32 offen offset:3072 nt lds
  s_add_u32 s32, s32, 4096
  s_mov_b32 m0, s58
  s_add_u32 s58, s58, 4096
  buffer_load_dwordx4 v1, s[20:23], s32 offen offset:0 nt lds
  buffer_load_dwordx4 v2, s[20:23], s32 offen offset:1024 nt lds
  buffer_load_dwordx4 v3, s[20:23], s32 offen offset:2048 nt lds
  buffer_load_dwordx4 v4, s[20:23], s32 offen offset:3072 nt lds
  s_cmp_eq_u32 s58, 49152
  s_cselect_b32 s58, 0, s58
  s_add_u32 s56, s56, 8
  s_add_u32 s32, s56, s57
  s_and_b32 s32, s32, 511
  s_lshl_b32 s32, s32, 14
  s_mov_b32 m0, s58
  s_add_u32 s58, s58, 4096
  buffer_load_dwordx4 v1, s[20:23], s32 offen offset:0 nt lds
  buffer_load_dwordx4 v2, s[20:23], s32 offen offset:1024 nt lds
  buffer_load_dwordx4 v3, s[20:23], s32 offen offset:2048 nt lds
  buffer_load_dwordx4 v4, s[20:23], s32 offen offset:3072 nt lds
  s_add_u32 s32, s32, 4096
  s_mov_b32 m0, s58
  s_add_u32 s58, s58, 4096
  buffer_load_dwordx4 v1, s[20:23], s32 offen offset:0 nt lds
  buffer_load_dwordx4 v2, s[20:23], s32 offen offset:1024 nt lds
  buffer_load_dwordx4 v3, s[20:23], s32 offen offset:2048 nt lds
  buffer_load_dwordx4 v4, s[20:23], s32 offen offset:3072 nt lds
  s_add_u32 s32, s32, 4096
  s_mov_b32 m0, s58
  s_add_u32 s58, s58, 4096
  buffer_load_dwordx4 v1, s[20:23], s32 offen offset:0 nt lds
  buffer_load_dwordx4 v2, s[20:23], s32 offen offset:1024 nt lds
  buffer_load_dwordx4 v3, s[20:23], s32 offen offset:2048 nt lds
  buffer_load_dwordx4 v4, s[20:23], s32 offen offset:3072 nt lds
  s_add_u32 s32, s32, 4096
  s_mov_b32 m0, s58
  s_add_u32 s58, s58, 4096
  buffer_load_dwordx4 v1, s[20:23], s32 offen offset:0 nt lds
  buffer_load_dwordx4 v2, s[20:23], s32 offen offset:1024 nt lds
  buffer_load_dwordx4 v3, s[20:23], s32 offen offset:2048 nt lds
  buffer_load_dwordx4 v4, s[20:23], s32 offen offset:3072 nt lds
  s_cmp_eq_u32 s58, 49152
  s_cselect_b32 s58, 0, s58
  s_add_u32 s56, s56, 8
  s_add_u32 s24, s8, s43
  s_addc_u32 s25, s9, 0
  s_and_b32 s25, s25, 0xffff
  s_mov_b32 s26, 0x800000
  s_mov_b32 s27, 0x20000
  s_load_dwordx2 s[14:15], s[0:1], 40
  s_load_dwordx2 s[16:17], s[0:1], 48
  v_lshlrev_b32 v35, 4, v0
  v_mov_b32 v8, 110592
  v_mov_b32 v9, 1
  ds_write_b32 v8, v9
  s_mov_b32 s62, 1
  s_waitcnt lgkmcnt(0)
  s_mul_i32 s18, s35, 4352
  s_add_u32 s18, s18, 524288
  s_add_u32 s68, s16, s18
  s_addc_u32 s69, s17, 0
  s_lshl_b32 s18, s35, 3
  s_add_u32 s18, s18, 4
  s_add_u32 s70, s14, s18
  s_addc_u32 s71, s15, 0
  s_mov_b32 s66, 0
  s_mov_b32 s62, 2
  s_mov_b32 s59, 3
standalone__linear_kernel_rfa__decode_kernel_lloop:
  s_cmp_eq_u32 s62, 1
  s_cbranch_scc1 standalone__linear_kernel_rfa__decode_kernel_lwa
  s_cmp_eq_u32 s62, 0
  s_cbranch_scc1 standalone__linear_kernel_rfa__decode_kernel_lw0
  s_waitcnt vmcnt(32)
  s_branch standalone__linear_kernel_rfa__decode_kernel_lw1
standalone__linear_kernel_rfa__decode_kernel_lw0:
  s_waitcnt vmcnt(0)
  s_branch standalone__linear_kernel_rfa__decode_kernel_lw1
standalone__linear_kernel_rfa__decode_kernel_lwa:
  s_waitcnt vmcnt(16)
standalone__linear_kernel_rfa__decode_kernel_lw1:
  s_barrier
  s_barrier
  s_cmp_lg_u32 s62, 2
  s_cbranch_scc1 standalone__linear_kernel_rfa__decode_kernel_lnorm
  s_cmp_ge_u32 s59, 9
  s_cbranch_scc1 standalone__linear_kernel_rfa__decode_kernel_ldrop
  s_mov_b32 s63, 2
  s_branch standalone__linear_kernel_rfa__decode_kernel_lK0
standalone__linear_kernel_rfa__decode_kernel_ldrop:
  s_mov_b32 s62, 1
  s_branch standalone__linear_kernel_rfa__decode_kernel_lloop
standalone__linear_kernel_rfa__decode_kernel_lnorm:
  s_mov_b32 s63, 1
  s_cmp_lt_u32 s59, 60
  s_cbranch_scc1 standalone__linear_kernel_rfa__decode_kernel_lK
  s_cmp_lg_u32 s59, 60
  s_cbranch_scc1 standalone__linear_kernel_rfa__decode_kernel_lnv0
  s_mov_b32 s56, s36
standalone__linear_kernel_rfa__decode_kernel_lnv0:
  s_cmp_lt_u32 s59, 118
  s_cbranch_scc1 standalone__linear_kernel_rfa__decode_kernel_lVs
  s_bitcmp1_b32 s59, 0
  s_cbranch_scc1 standalone__linear_kernel_rfa__decode_kernel_lodd
  s_cmp_lt_u32 s59, 120
  s_cbranch_scc1 standalone__linear_kernel_rfa__decode_kernel_lfirst
  s_waitcnt lgkmcnt(0)
  s_cmp_ge_u32 s64, 32
  s_cbranch_scc1 standalone__linear_kernel_rfa__decode_kernel_lnone
  s_add_u32 s65, s64, 480
  s_mov_b32 s64, 1
  s_atomic_add s64, s[68:69], 0 glc
  s_mov_b32 s56, s65
  s_branch standalone__linear_kernel_rfa__decode_kernel_lK
standalone__linear_kernel_rfa__decode_kernel_lfirst:
  s_waitcnt lgkmcnt(0)
  s_cmp_eq_u32 s66, 1
  s_cbranch_scc1 standalone__linear_kernel_rfa__decode_kernel_lcl
  s_mov_b32 s19, 0x40000
standalone__linear_kernel_rfa__decode_kernel_lfw:
  s_mov_b32 s66, 0
  s_atomic_add s66, s[70:71], 0 glc
  s_waitcnt lgkmcnt(0)
  s_sub_u32 s19, s19, 1
  s_cmp_eq_u32 s19, 0
  s_cbranch_scc1 standalone__linear_kernel_rfa__decode_kernel_lcl
  s_cmp_lg_u32 s66, 1
  s_cbranch_scc1 standalone__linear_kernel_rfa__decode_kernel_lfw
standalone__linear_kernel_rfa__decode_kernel_lcl:
  s_mov_b32 s64, 1
  s_atomic_add s64, s[68:69], 0 glc
  s_branch standalone__linear_kernel_rfa__decode_kernel_lVs
standalone__linear_kernel_rfa__decode_kernel_lodd:
  s_cmp_lt_u32 s59, 120
  s_cbranch_scc1 standalone__linear_kernel_rfa__decode_kernel_lVs
  s_cmp_eq_u32 s62, 0
  s_cbranch_scc1 standalone__linear_kernel_rfa__decode_kernel_lnone
  s_mov_b32 s56, s65
  s_branch standalone__linear_kernel_rfa__decode_kernel_lVs
standalone__linear_kernel_rfa__decode_kernel_lK:
standalone__linear_kernel_rfa__decode_kernel_lK0:
  s_add_u32 s32, s56, s57
  s_and_b32 s32, s32, 511
  s_lshl_b32 s32, s32, 14
  s_mov_b32 m0, s58
  s_add_u32 s58, s58, 4096
  buffer_load_dwordx4 v1, s[20:23], s32 offen offset:0 nt lds
  buffer_load_dwordx4 v2, s[20:23], s32 offen offset:1024 nt lds
  buffer_load_dwordx4 v3, s[20:23], s32 offen offset:2048 nt lds
  buffer_load_dwordx4 v4, s[20:23], s32 offen offset:3072 nt lds
  s_add_u32 s32, s32, 4096
  s_mov_b32 m0, s58
  s_add_u32 s58, s58, 4096
  buffer_load_dwordx4 v1, s[20:23], s32 offen offset:0 nt lds
  buffer_load_dwordx4 v2, s[20:23], s32 offen offset:1024 nt lds
  buffer_load_dwordx4 v3, s[20:23], s32 offen offset:2048 nt lds
  buffer_load_dwordx4 v4, s[20:23], s32 offen offset:3072 nt lds
  s_add_u32 s32, s32, 4096
  s_mov_b32 m0, s58
  s_add_u32 s58, s58, 4096
  buffer_load_dwordx4 v1, s[20:23], s32 offen offset:0 nt lds
  buffer_load_dwordx4 v2, s[20:23], s32 offen offset:1024 nt lds
  buffer_load_dwordx4 v3, s[20:23], s32 offen offset:2048 nt lds
  buffer_load_dwordx4 v4, s[20:23], s32 offen offset:3072 nt lds
  s_add_u32 s32, s32, 4096
  s_mov_b32 m0, s58
  s_add_u32 s58, s58, 4096
  buffer_load_dwordx4 v1, s[20:23], s32 offen offset:0 nt lds
  buffer_load_dwordx4 v2, s[20:23], s32 offen offset:1024 nt lds
  buffer_load_dwordx4 v3, s[20:23], s32 offen offset:2048 nt lds
  buffer_load_dwordx4 v4, s[20:23], s32 offen offset:3072 nt lds
  s_cmp_eq_u32 s58, 49152
  s_cselect_b32 s58, 0, s58
  s_branch standalone__linear_kernel_rfa__decode_kernel_ladv
standalone__linear_kernel_rfa__decode_kernel_lVs:
  s_add_u32 s32, s56, s57
  s_and_b32 s32, s32, 511
  s_lshl_b32 s32, s32, 14
  s_mov_b32 m0, s58
  s_add_u32 s58, s58, 4096
  buffer_load_dwordx4 v35, s[24:27], s32 offen offset:0 nt lds
  buffer_load_dwordx4 v35, s[24:27], s32 offen offset:1024 nt lds
  buffer_load_dwordx4 v35, s[24:27], s32 offen offset:2048 nt lds
  buffer_load_dwordx4 v35, s[24:27], s32 offen offset:3072 nt lds
  s_add_u32 s32, s32, 4096
  s_mov_b32 m0, s58
  s_add_u32 s58, s58, 4096
  buffer_load_dwordx4 v35, s[24:27], s32 offen offset:0 nt lds
  buffer_load_dwordx4 v35, s[24:27], s32 offen offset:1024 nt lds
  buffer_load_dwordx4 v35, s[24:27], s32 offen offset:2048 nt lds
  buffer_load_dwordx4 v35, s[24:27], s32 offen offset:3072 nt lds
  s_add_u32 s32, s32, 4096
  s_mov_b32 m0, s58
  s_add_u32 s58, s58, 4096
  buffer_load_dwordx4 v35, s[24:27], s32 offen offset:0 nt lds
  buffer_load_dwordx4 v35, s[24:27], s32 offen offset:1024 nt lds
  buffer_load_dwordx4 v35, s[24:27], s32 offen offset:2048 nt lds
  buffer_load_dwordx4 v35, s[24:27], s32 offen offset:3072 nt lds
  s_add_u32 s32, s32, 4096
  s_mov_b32 m0, s58
  s_add_u32 s58, s58, 4096
  buffer_load_dwordx4 v35, s[24:27], s32 offen offset:0 nt lds
  buffer_load_dwordx4 v35, s[24:27], s32 offen offset:1024 nt lds
  buffer_load_dwordx4 v35, s[24:27], s32 offen offset:2048 nt lds
  buffer_load_dwordx4 v35, s[24:27], s32 offen offset:3072 nt lds
  s_cmp_eq_u32 s58, 49152
  s_cselect_b32 s58, 0, s58
standalone__linear_kernel_rfa__decode_kernel_ladv:
  s_add_u32 s56, s56, 8
  s_cmp_lg_u32 s59, 12
  s_cbranch_scc1 standalone__linear_kernel_rfa__decode_kernel_lnx
  s_load_dword s66, s[70:71], 0
  s_branch standalone__linear_kernel_rfa__decode_kernel_lnx
standalone__linear_kernel_rfa__decode_kernel_lnone:
  s_mov_b32 s63, 0
  s_cmp_eq_u32 s62, 0
  s_cbranch_scc1 standalone__linear_kernel_rfa__decode_kernel_lstop
  v_mov_b32 v8, 110592
  v_mov_b32 v9, 0
  ds_write_b32 v8, v9
  s_waitcnt lgkmcnt(0)
standalone__linear_kernel_rfa__decode_kernel_lnx:
  s_add_u32 s59, s59, 1
  s_mov_b32 s62, s63
  s_branch standalone__linear_kernel_rfa__decode_kernel_lloop
standalone__linear_kernel_rfa__decode_kernel_lstop:
  s_endpgm
standalone__linear_kernel_rfa__decode_kernel_consumer:
  v_and_b32 v9, 15, v0
  v_lshrrev_b32 v11, 4, v0
  v_lshlrev_b32 v10, 4, v11
  v_lshl_or_b32 v8, v9, 8, v10
  s_lshl_b32 s18, s35, 8
  s_mov_b32 s30, 256
  s_mov_b32 s31, 0x20000
  s_mov_b32 s50, 2048
  s_mov_b32 s51, 0x20000
  s_waitcnt lgkmcnt(0)
  s_mov_b32 s48, s10
  s_and_b32 s49, s11, 0xffff
  s_add_u32 s28, s4, s18
  s_addc_u32 s29, s5, 0
  s_and_b32 s29, s29, 0xffff
  buffer_load_dwordx4 a[0:3], v8, s[48:51], 0 offen offset:0
  buffer_load_dwordx4 a[4:7], v8, s[48:51], 0 offen offset:64
  buffer_load_dwordx4 a[8:11], v8, s[48:51], 0 offen offset:128
  buffer_load_dwordx4 a[12:15], v8, s[48:51], 0 offen offset:192
  buffer_load_dwordx4 v[36:39], v10, s[28:31], 0 offen offset:0
  buffer_load_dwordx4 v[40:43], v10, s[28:31], 0 offen offset:64
  buffer_load_dwordx4 v[44:47], v10, s[28:31], 0 offen offset:128
  buffer_load_dwordx4 v[48:51], v10, s[28:31], 0 offen offset:192
  s_load_dwordx4 s[12:15], s[0:1], 32
  s_load_dwordx2 s[16:17], s[0:1], 48
  s_sub_u32 s3, s3, 1
  v_and_b32 v8, 3, v0
  v_lshlrev_b32 v8, 10, v8
  v_bfe_u32 v10, v0, 2, 2
  v_lshl_or_b32 v8, v10, 8, v8
  s_lshl_b32 s43, s3, 13
  v_add_u32 v8, s43, v8
  v_or_b32 v10, 0, v11
  v_xor_b32 v10, v10, v9
  v_lshl_add_u32 v140, v10, 4, v8
  v_or_b32 v10, 4, v11
  v_xor_b32 v10, v10, v9
  v_lshl_add_u32 v141, v10, 4, v8
  v_or_b32 v10, 8, v11
  v_xor_b32 v10, v10, v9
  v_lshl_add_u32 v142, v10, 4, v8
  v_or_b32 v10, 12, v11
  v_xor_b32 v10, v10, v9
  v_lshl_add_u32 v143, v10, 4, v8
  v_and_b32 v10, 7, v0
  v_lshl_or_b32 v10, v11, 3, v10
  v_lshlrev_b32 v10, 4, v10
  s_lshl_b32 s44, s3, 9
  s_add_u32 s44, s44, 49152
  v_add_u32 v6, s44, v10
  s_mov_b32 s39, 0x3edb9ada
  s_mov_b32 s41, 0x358637bd
  s_mov_b32 s42, 0xbe1837f0
  s_mov_b32 s60, 0x00ff00ff
  s_mov_b32 s61, 0x00ff00ff
  s_mov_b32 s59, 0
  s_mov_b32 s33, 0
  v_mov_b32 v7, s42
  v_and_b32 v10, 8, v0
  v_cmp_eq_u32 vcc, 0, v10
  v_mov_b32 v11, s41
  v_mov_b32 v8, 0x3eb504f3
  s_waitcnt vmcnt(0) lgkmcnt(0)
  v_mfma_f32_16x16x32_bf16 v[12:15], v[36:39], a[0:3], 0
  v_mfma_f32_16x16x32_bf16 v[16:19], v[36:39], v[36:39], 0
  v_mfma_f32_16x16x32_bf16 v[12:15], v[40:43], a[4:7], v[12:15]
  v_mfma_f32_16x16x32_bf16 v[16:19], v[40:43], v[40:43], v[16:19]
  v_mfma_f32_16x16x32_bf16 v[12:15], v[44:47], a[8:11], v[12:15]
  v_mfma_f32_16x16x32_bf16 v[16:19], v[44:47], v[44:47], v[16:19]
  v_mfma_f32_16x16x32_bf16 v[12:15], v[48:51], a[12:15], v[12:15]
  v_mfma_f32_16x16x32_bf16 v[16:19], v[48:51], v[48:51], v[16:19]
  s_mul_i32 s18, s35, 4352
  s_add_u32 s18, s18, 524288
  s_add_u32 s52, s16, s18
  s_addc_u32 s53, s17, 0
  s_and_b32 s53, s53, 0xffff
  s_mov_b32 s54, 8
  s_mov_b32 s55, 0x20000
  v_mov_b32 v34, 0
  v_lshlrev_b32 v35, 4, v0
  v_fma_f32 v32, v16, s42, v12
  v_mul_f32 v32, s39, v32
  v_exp_f32 v32, v32
  s_nop 0
  v_fma_f32 v32, v32, v8, v11
  v_mul_f32 v11, v32, v11
  v_mul_f32 v32, v32, v8
  v_cndmask_b32 v11, 0, v11, vcc
  v_cndmask_b32 v32, 0, v32, vcc
  v_mov_b32 v41, v35
  v_mov_b32 v42, v35
  v_mov_b32 v43, v35
  v_mov_b32 v44, v35
  v_mov_b32 v45, v35
  v_mov_b32 v1, v140
  v_mov_b32 v2, v141
  v_mov_b32 v3, v142
  v_mov_b32 v4, v143
standalone__linear_kernel_rfa__decode_kernel_cloop:
  s_barrier
  s_cmp_lt_u32 s59, 60
  s_cbranch_scc1 standalone__linear_kernel_rfa__decode_kernel_cK
  s_cmp_lt_u32 s59, 120
  s_cbranch_scc1 standalone__linear_kernel_rfa__decode_kernel_cV
  s_bitcmp1_b32 s59, 0
  s_cbranch_scc1 standalone__linear_kernel_rfa__decode_kernel_cV
standalone__linear_kernel_rfa__decode_kernel_cK:
  ds_read_b128 v[88:91], v1 offset:0
  ds_read_b128 v[104:107], v1 offset:4096
  ds_read_b128 v[92:95], v2 offset:0
  ds_read_b128 v[108:111], v2 offset:4096
  ds_read_b128 v[96:99], v3 offset:0
  ds_read_b128 v[112:115], v3 offset:4096
  ds_read_b128 v[100:103], v4 offset:0
  ds_read_b128 v[116:119], v4 offset:4096
  s_waitcnt lgkmcnt(6)
  v_mfma_f32_16x16x32_bf16 v[12:15], v[88:91], a[0:3], 0
  v_mfma_f32_16x16x32_bf16 v[16:19], v[104:107], a[0:3], 0
  v_dot2_f32_bf16 v8, v88, v88, 0
  v_dot2_f32_bf16 v9, v104, v104, 0
  v_dot2_f32_bf16 v8, v89, v89, v8
  v_dot2_f32_bf16 v9, v105, v105, v9
  v_dot2_f32_bf16 v8, v90, v90, v8
  v_dot2_f32_bf16 v9, v106, v106, v9
  v_dot2_f32_bf16 v8, v91, v91, v8
  v_dot2_f32_bf16 v9, v107, v107, v9
  s_waitcnt lgkmcnt(4)
  v_mfma_f32_16x16x32_bf16 v[12:15], v[92:95], a[4:7], v[12:15]
  v_mfma_f32_16x16x32_bf16 v[16:19], v[108:111], a[4:7], v[16:19]
  v_dot2_f32_bf16 v8, v92, v92, v8
  v_dot2_f32_bf16 v9, v108, v108, v9
  v_dot2_f32_bf16 v8, v93, v93, v8
  v_dot2_f32_bf16 v9, v109, v109, v9
  v_dot2_f32_bf16 v8, v94, v94, v8
  v_dot2_f32_bf16 v9, v110, v110, v9
  v_dot2_f32_bf16 v8, v95, v95, v8
  v_dot2_f32_bf16 v9, v111, v111, v9
  s_waitcnt lgkmcnt(2)
  v_mfma_f32_16x16x32_bf16 v[12:15], v[96:99], a[8:11], v[12:15]
  v_mfma_f32_16x16x32_bf16 v[16:19], v[112:115], a[8:11], v[16:19]
  v_dot2_f32_bf16 v8, v96, v96, v8
  v_dot2_f32_bf16 v9, v112, v112, v9
  v_dot2_f32_bf16 v8, v97, v97, v8
  v_dot2_f32_bf16 v9, v113, v113, v9
  v_dot2_f32_bf16 v8, v98, v98, v8
  v_dot2_f32_bf16 v9, v114, v114, v9
  v_dot2_f32_bf16 v8, v99, v99, v8
  v_dot2_f32_bf16 v9, v115, v115, v9
  s_waitcnt lgkmcnt(0)
  v_mfma_f32_16x16x32_bf16 v[12:15], v[100:103], a[12:15], v[12:15]
  v_mfma_f32_16x16x32_bf16 v[16:19], v[116:119], a[12:15], v[16:19]
  v_dot2_f32_bf16 v8, v100, v100, v8
  v_dot2_f32_bf16 v9, v116, v116, v9
  v_dot2_f32_bf16 v8, v101, v101, v8
  v_dot2_f32_bf16 v9, v117, v117, v9
  v_dot2_f32_bf16 v8, v102, v102, v8
  v_dot2_f32_bf16 v9, v118, v118, v9
  v_dot2_f32_bf16 v8, v103, v103, v8
  v_dot2_f32_bf16 v9, v119, v119, v9
  s_barrier
  s_nop 1
  v_mfma_f32_16x16x4_f32 v[12:15], v8, v7, v[12:15]
  v_mfma_f32_16x16x4_f32 v[16:19], v9, v7, v[16:19]
  s_add_u32 s33, s33, 16384
  s_cmp_eq_u32 s33, 49152
  s_cselect_b32 s33, 0, s33
  v_add_u32 v1, s33, v140
  v_add_u32 v2, s33, v141
  v_add_u32 v3, s33, v142
  v_add_u32 v4, s33, v143
  v_add_u32 v5, s33, v144
  s_nop 1
  v_mul_f32 v12, s39, v12
  v_mul_f32 v13, s39, v13
  v_mul_f32 v14, s39, v14
  v_mul_f32 v15, s39, v15
  v_mul_f32 v16, s39, v16
  v_mul_f32 v17, s39, v17
  v_mul_f32 v18, s39, v18
  v_mul_f32 v19, s39, v19
  v_exp_f32 v12, v12
  v_exp_f32 v13, v13
  v_exp_f32 v14, v14
  v_exp_f32 v15, v15
  v_exp_f32 v16, v16
  v_exp_f32 v17, v17
  v_exp_f32 v18, v18
  v_exp_f32 v19, v19
  v_fma_f32 v12, v12, v32, v11
  v_fma_f32 v13, v13, v32, v11
  v_fma_f32 v14, v14, v32, v11
  v_fma_f32 v15, v15, v32, v11
  v_fma_f32 v16, v16, v32, v11
  v_fma_f32 v17, v17, v32, v11
  v_fma_f32 v18, v18, v32, v11
  v_fma_f32 v19, v19, v32, v11
  v_cvt_pk_bf16_f32 v20, v12, v13
  v_cvt_pk_bf16_f32 v21, v14, v15
  v_cvt_pk_bf16_f32 v22, v16, v17
  v_cvt_pk_bf16_f32 v23, v18, v19
  s_cmp_ge_u32 s59, 60
  s_cbranch_scc1 standalone__linear_kernel_rfa__decode_kernel_cnext
  s_mov_b64 exec, s[60:61]
  ds_write_b128 v6, v[20:23]
  s_mov_b64 exec, -1
  v_add_u32 v6, 1024, v6
  s_cmp_gt_u32 s59, 3
  s_cbranch_scc1 standalone__linear_kernel_rfa__decode_kernel_cnext
  s_cmp_eq_u32 s59, 1
  s_cbranch_scc1 standalone__linear_kernel_rfa__decode_kernel_setup
  s_cmp_lg_u32 s59, 3
  s_cbranch_scc1 standalone__linear_kernel_rfa__decode_kernel_cnext
  s_or_b32 s18, s36, s3
  s_cmp_lg_u32 s18, 0
  s_cbranch_scc1 standalone__linear_kernel_rfa__decode_kernel_cnext
  s_waitcnt vmcnt(0)
  s_lshl_b32 s18, s35, 3
  s_add_u32 s18, s18, 4
  s_mov_b64 exec, 1
  v_mov_b32 v8, 1
  buffer_store_dword v8, v34, s[48:51], s18 offen sc1
  s_mov_b64 exec, -1
standalone__linear_kernel_rfa__decode_kernel_cnext:
  s_add_u32 s59, s59, 1
  s_branch standalone__linear_kernel_rfa__decode_kernel_cloop
standalone__linear_kernel_rfa__decode_kernel_setup:
  v_mov_b32 v52, 0
  v_mov_b32 v53, 0
  v_mov_b32 v54, 0
  v_mov_b32 v55, 0
  v_mov_b32 v56, 0
  v_mov_b32 v57, 0
  v_mov_b32 v58, 0
  v_mov_b32 v59, 0
  v_mov_b32 v60, 0
  v_mov_b32 v61, 0
  v_mov_b32 v62, 0
  v_mov_b32 v63, 0
  v_mov_b32 v64, 0
  v_mov_b32 v65, 0
  v_mov_b32 v66, 0
  v_mov_b32 v67, 0
  v_mov_b32 v68, 0
  v_mov_b32 v69, 0
  v_mov_b32 v70, 0
  v_mov_b32 v71, 0
  v_mov_b32 v72, 0
  v_mov_b32 v73, 0
  v_mov_b32 v74, 0
  v_mov_b32 v75, 0
  v_mov_b32 v76, 0
  v_mov_b32 v77, 0
  v_mov_b32 v78, 0
  v_mov_b32 v79, 0
  v_mov_b32 v80, 0
  v_mov_b32 v81, 0
  v_mov_b32 v82, 0
  v_mov_b32 v83, 0
  v_mov_b32 v84, 0
  v_mov_b32 v85, 0
  v_mov_b32 v86, 0
  v_mov_b32 v87, 0
  v_mov_b32 v9, 0x3f803f80
  v_accvgpr_write_b32 a16, v9
  v_accvgpr_write_b32 a17, v9
  v_accvgpr_write_b32 a18, v9
  v_accvgpr_write_b32 a19, v9
  s_mov_b32 s37, 0x05040100
  s_mov_b32 s38, 0x07060302
  s_lshl_b32 s43, s3, 13
  v_add_u32 v144, s43, v35
  v_subrev_u32 v51, 2048, v6
  v_mov_b32 v48, 110592
  v_and_b32 v9, 15, v0
  v_lshrrev_b32 v8, 4, v0
  v_lshlrev_b32 v8, 4, v8
  v_lshl_or_b32 v33, v9, 5, v8
  s_mov_b32 s48, s14
  s_and_b32 s49, s15, 0xffff
  s_mov_b32 s50, 256
  s_mov_b32 s51, 0x20000
  s_mov_b32 s28, s16
  s_and_b32 s29, s17, 0xffff
  s_mov_b32 s30, 163840
  s_mov_b32 s31, 0x20000
  s_cmp_lg_u32 s3, 0
  s_cbranch_scc1 standalone__linear_kernel_rfa__decode_kernel_cnext
  s_lshl_b32 s18, s35, 23
  s_add_u32 s24, s8, s18
  s_addc_u32 s25, s9, 0
  s_and_b32 s25, s25, 0xffff
  s_mov_b32 s26, 0x800000
  s_mov_b32 s27, 0x20000
  s_mul_i32 s18, s35, 16
  s_add_u32 s18, s18, s36
  s_and_b32 s18, s18, 511
  s_lshl_b32 s18, s18, 14
  s_mov_b64 exec, 1
  buffer_load_dword v40, v34, s[24:27], s18 offen nt
  s_mov_b64 exec, -1
  v_lshrrev_b32 v8, 5, v0
  v_mov_b32 v9, 0x7ffffff0
  v_add_u32 v10, 0, v8
  v_cmp_eq_u32 vcc, s36, v10
  s_nop 1
  v_cndmask_b32 v41, v35, v9, vcc
  v_add_u32 v10, 2, v8
  v_cmp_eq_u32 vcc, s36, v10
  s_nop 1
  v_cndmask_b32 v42, v35, v9, vcc
  v_add_u32 v10, 4, v8
  v_cmp_eq_u32 vcc, s36, v10
  s_nop 1
  v_cndmask_b32 v43, v35, v9, vcc
  v_add_u32 v10, 6, v8
  v_cmp_eq_u32 vcc, s36, v10
  s_nop 1
  v_cndmask_b32 v44, v35, v9, vcc
  v_and_b32 v10, 7, v0
  v_cmp_eq_u32 vcc, s36, v10
  v_lshlrev_b32 v10, 7, v10
  s_nop 0
  v_cndmask_b32 v45, v10, v9, vcc
  s_lshl_b32 s18, s35, 3
  s_add_u32 s18, s18, s36
  s_lshl_b32 s19, s18, 7
  s_add_u32 s19, s19, 131072
  s_lshl_b32 s18, s18, 9
  v_mov_b32 v24, -1
  v_mov_b32 v25, -1
  v_mov_b32 v26, -1
  v_mov_b32 v27, -1
  v_lshlrev_b32 v28, 2, v0
  s_mov_b32 exec_hi, 0
  buffer_store_dwordx4 v[24:27], v35, s[28:31], s18 offen sc1
  buffer_store_dword v24, v28, s[28:31], s19 offen sc1
  s_mov_b64 exec, -1
  s_cmp_lg_u32 s36, 0
  s_cbranch_scc1 standalone__linear_kernel_rfa__decode_kernel_cnext
  v_mov_b32 v46, 0
  v_mov_b32 v47, 0
  s_mov_b64 exec, 1
  buffer_atomic_swap_x2 v[46:47], v34, s[52:55], 0 offen sc0
  s_mov_b64 exec, -1
  s_branch standalone__linear_kernel_rfa__decode_kernel_cnext
standalone__linear_kernel_rfa__decode_kernel_cV:
  s_cmp_ge_u32 s59, 120
  s_cbranch_scc1 standalone__linear_kernel_rfa__decode_kernel_cV2
  s_mov_b64 exec, s[60:61]
  ds_read_b128 v[20:23], v51
  s_mov_b64 exec, -1
  v_add_u32 v51, 1024, v51
standalone__linear_kernel_rfa__decode_kernel_cV2:
  ds_read_b32 v50, v48
  ds_read_b128 v[88:91], v5 offset:0
  ds_read_b128 v[92:95], v5 offset:1024
  ds_read_b128 v[96:99], v5 offset:2048
  ds_read_b128 v[100:103], v5 offset:3072
  ds_read_b128 v[104:107], v5 offset:4096
  ds_read_b128 v[108:111], v5 offset:5120
  ds_read_b128 v[112:115], v5 offset:6144
  ds_read_b128 v[116:119], v5 offset:7168
  s_add_u32 s33, s33, 16384
  s_cmp_eq_u32 s33, 49152
  s_cselect_b32 s33, 0, s33
  v_add_u32 v1, s33, v140
  v_add_u32 v2, s33, v141
  v_add_u32 v3, s33, v142
  v_add_u32 v4, s33, v143
  v_add_u32 v5, s33, v144
  s_waitcnt lgkmcnt(0)
  v_readfirstlane_b32 s18, v50
  v_perm_b32 v24, v92, v88, s37
  v_perm_b32 v25, v100, v96, s37
  v_perm_b32 v26, v108, v104, s37
  v_perm_b32 v27, v116, v112, s37
  s_or_b32 s19, s18, s3
  s_cmp_lg_u32 s19, 0
  s_cbranch_scc1 standalone__linear_kernel_rfa__decode_kernel_narr
  s_mov_b32 s19, 4
  s_waitcnt vmcnt(0)
  s_mov_b64 exec, 1
  v_mov_b32 v49, 1
  buffer_atomic_add v49, v34, s[52:55], s19 offen sc0
  s_mov_b64 exec, -1
standalone__linear_kernel_rfa__decode_kernel_narr:
  v_perm_b32 v28, v92, v88, s38
  v_perm_b32 v29, v100, v96, s38
  v_perm_b32 v30, v108, v104, s38
  v_perm_b32 v31, v116, v112, s38
  v_mfma_f32_16x16x32_bf16 v[84:87], v[20:23], a[16:19], v[84:87]
  v_mfma_f32_16x16x32_bf16 v[52:55], v[20:23], v[24:27], v[52:55]
  v_perm_b32 v24, v93, v89, s37
  v_perm_b32 v25, v101, v97, s37
  v_perm_b32 v26, v109, v105, s37
  v_perm_b32 v27, v117, v113, s37
  v_mfma_f32_16x16x32_bf16 v[56:59], v[20:23], v[28:31], v[56:59]
  v_perm_b32 v28, v93, v89, s38
  v_perm_b32 v29, v101, v97, s38
  v_perm_b32 v30, v109, v105, s38
  v_perm_b32 v31, v117, v113, s38
  v_mfma_f32_16x16x32_bf16 v[60:63], v[20:23], v[24:27], v[60:63]
  v_perm_b32 v24, v94, v90, s37
  v_perm_b32 v25, v102, v98, s37
  v_perm_b32 v26, v110, v106, s37
  v_perm_b32 v27, v118, v114, s37
  v_mfma_f32_16x16x32_bf16 v[64:67], v[20:23], v[28:31], v[64:67]
  v_perm_b32 v28, v94, v90, s38
  v_perm_b32 v29, v102, v98, s38
  v_perm_b32 v30, v110, v106, s38
  v_perm_b32 v31, v118, v114, s38
  v_mfma_f32_16x16x32_bf16 v[68:71], v[20:23], v[24:27], v[68:71]
  v_perm_b32 v24, v95, v91, s37
  v_perm_b32 v25, v103, v99, s37
  v_perm_b32 v26, v111, v107, s37
  v_perm_b32 v27, v119, v115, s37
  s_barrier
  v_mfma_f32_16x16x32_bf16 v[72:75], v[20:23], v[28:31], v[72:75]
  v_perm_b32 v28, v95, v91, s38
  v_perm_b32 v29, v103, v99, s38
  v_perm_b32 v30, v111, v107, s38
  v_perm_b32 v31, v119, v115, s38
  v_mfma_f32_16x16x32_bf16 v[76:79], v[20:23], v[24:27], v[76:79]
  s_nop 0
  v_mfma_f32_16x16x32_bf16 v[80:83], v[20:23], v[28:31], v[80:83]
  s_add_u32 s59, s59, 1
  s_cmp_lg_u32 s18, 0
  s_cbranch_scc1 standalone__linear_kernel_rfa__decode_kernel_cloop
standalone__linear_kernel_rfa__decode_kernel_fin:
  s_nop 5
  v_add_f32 v52, v52, v53
  v_add_f32 v56, v56, v57
  v_add_f32 v60, v60, v61
  v_add_f32 v64, v64, v65
  v_add_f32 v68, v68, v69
  v_add_f32 v72, v72, v73
  v_add_f32 v76, v76, v77
  v_add_f32 v80, v80, v81
  v_add_f32 v84, v84, v85
  v_add_f32 v54, v54, v55
  v_add_f32 v58, v58, v59
  v_add_f32 v62, v62, v63
  v_add_f32 v66, v66, v67
  v_add_f32 v70, v70, v71
  v_add_f32 v74, v74, v75
  v_add_f32 v78, v78, v79
  v_add_f32 v82, v82, v83
  v_add_f32 v86, v86, v87
  v_add_f32 v52, v52, v54
  v_add_f32 v56, v56, v58
  v_add_f32 v60, v60, v62
  v_add_f32 v64, v64, v66
  v_add_f32 v68, v68, v70
  v_add_f32 v72, v72, v74
  v_add_f32 v76, v76, v78
  v_add_f32 v80, v80, v82
  v_add_f32 v84, v84, v86
  v_mov_b32 v36, v52
  v_mov_b32 v37, v56
  v_mov_b32 v38, v60
  v_mov_b32 v39, v64
  v_mov_b32 v40, v84
  s_nop 0
  v_permlane16_swap_b32 v36, v68
  v_permlane16_swap_b32 v37, v72
  v_permlane16_swap_b32 v38, v76
  v_permlane16_swap_b32 v39, v80
  v_permlane16_swap_b32 v40, v84
  v_add_f32 v36, v36, v68
  v_add_f32 v37, v37, v72
  v_add_f32 v38, v38, v76
  v_add_f32 v39, v39, v80
  v_add_f32 v40, v40, v84
  v_lshlrev_b32 v10, 2, v0
  s_cmp_eq_u32 s3, 0
  s_cbranch_scc1 standalone__linear_kernel_rfa__decode_kernel_c0
  ds_write_b128 v35, v[36:39] offset:0
  ds_write_b32 v10, v40 offset:1024
  s_waitcnt lgkmcnt(0)
  s_barrier
  s_branch standalone__linear_kernel_rfa__decode_kernel_end
standalone__linear_kernel_rfa__decode_kernel_c0:
  s_lshl_b32 s43, s35, 3
  s_add_u32 s43, s43, s36
  s_lshl_b32 s44, s43, 7
  s_add_u32 s44, s44, 131072
  s_lshl_b32 s43, s43, 9
  v_cmp_gt_u32 vcc, 32, v0
  s_barrier
  ds_read_b128 v[120:123], v35 offset:0
  ds_read_b32 v124, v10 offset:1024
  s_waitcnt vmcnt(0) lgkmcnt(0)
  v_readfirstlane_b32 s18, v49
  v_add_f32 v36, v36, v120
  v_add_f32 v37, v37, v121
  v_add_f32 v38, v38, v122
  v_add_f32 v39, v39, v123
  v_add_f32 v40, v40, v124
  s_cmp_eq_u32 s18, 7
  s_cbranch_scc1 standalone__linear_kernel_rfa__decode_kernel_last
  v_min_u32 v36, -2, v36
  v_min_u32 v37, -2, v37
  v_min_u32 v38, -2, v38
  v_min_u32 v39, -2, v39
  v_min_u32 v40, -2, v40
  s_and_saveexec_b64 s[46:47], vcc
  buffer_store_dwordx4 v[36:39], v35, s[28:31], s43 offen sc1
  buffer_store_dword v40, v10, s[28:31], s44 offen sc1
  s_branch standalone__linear_kernel_rfa__decode_kernel_end
standalone__linear_kernel_rfa__decode_kernel_last:
  s_lshl_b32 s43, s35, 12
  s_lshl_b32 s44, s35, 10
  s_add_u32 s44, s44, 131072
  s_mov_b32 s19, 0x40000
standalone__linear_kernel_rfa__decode_kernel_sweep:
  buffer_load_dwordx4 v[120:123], v41, s[28:31], s43 offen offset:0 sc1
  buffer_load_dwordx4 v[124:127], v42, s[28:31], s43 offen offset:1024 sc1
  buffer_load_dwordx4 v[128:131], v43, s[28:31], s43 offen offset:2048 sc1
  buffer_load_dwordx4 v[132:135], v44, s[28:31], s43 offen offset:3072 sc1
  buffer_load_dword v136, v45, s[28:31], s44 offen sc1
standalone__linear_kernel_rfa__decode_kernel_got:
  s_mov_b32 s48, s12
  s_and_b32 s49, s13, 0xffff
  s_mov_b32 s50, 8192
  s_mov_b32 s51, 0x20000
  s_waitcnt vmcnt(0)
  v_max3_u32 v8, v120, v121, v122
  v_max3_u32 v8, v8, v123, v124
  v_max3_u32 v8, v8, v125, v126
  v_max3_u32 v8, v8, v127, v128
  v_max3_u32 v8, v8, v129, v130
  v_max3_u32 v8, v8, v131, v132
  v_max3_u32 v8, v8, v133, v134
  v_max3_u32 v8, v8, v135, v136
  s_sub_u32 s19, s19, 1
  s_cmp_eq_u32 s19, 0
  s_cbranch_scc1 standalone__linear_kernel_rfa__decode_kernel_go
  v_cmp_eq_u32 vcc, -1, v8
  s_nop 1
  s_cbranch_vccnz standalone__linear_kernel_rfa__decode_kernel_sweep
standalone__linear_kernel_rfa__decode_kernel_go:
  v_add_f32_dpp v136, v136, v136 quad_perm:[1,0,3,2] row_mask:0xf bank_mask:0xf
  v_add_f32 v120, v120, v124
  v_add_f32 v121, v121, v125
  v_add_f32 v122, v122, v126
  v_add_f32 v123, v123, v127
  v_add_f32_dpp v136, v136, v136 quad_perm:[2,3,0,1] row_mask:0xf bank_mask:0xf
  v_add_f32 v120, v120, v128
  v_add_f32 v121, v121, v129
  v_add_f32 v122, v122, v130
  v_add_f32 v123, v123, v131
  v_add_f32_dpp v136, v136, v136 row_half_mirror row_mask:0xf bank_mask:0xf
  v_add_f32 v120, v120, v132
  v_add_f32 v121, v121, v133
  v_add_f32 v122, v122, v134
  v_add_f32 v123, v123, v135
  v_add_f32 v120, v120, v36
  v_add_f32 v121, v121, v37
  v_add_f32 v122, v122, v38
  v_add_f32 v123, v123, v39
  v_add_f32 v136, v136, v40
  v_mov_b32 v124, v120
  v_mov_b32 v125, v121
  v_mov_b32 v126, v122
  v_mov_b32 v127, v123
  v_add_f32 v136, s41, v136
  v_rcp_f32 v136, v136
  v_permlane32_swap_b32 v120, v124
  v_permlane32_swap_b32 v121, v125
  v_permlane32_swap_b32 v122, v126
  v_permlane32_swap_b32 v123, v127
  v_add_f32 v120, v120, v124
  v_add_f32 v121, v121, v125
  v_add_f32 v122, v122, v126
  v_add_f32 v123, v123, v127
  v_mul_f32 v120, v120, v136
  v_mul_f32 v121, v121, v136
  v_mul_f32 v122, v122, v136
  v_mul_f32 v123, v123, v136
  s_lshl_b32 s43, s35, 8
  v_lshrrev_b32 v10, 1, v33
  v_cvt_pk_bf16_f32 v120, v120, v121
  v_cvt_pk_bf16_f32 v121, v122, v123
  s_mov_b32 exec_hi, 0
  buffer_store_dwordx2 v[120:121], v10, s[48:51], s43 offen
standalone__linear_kernel_rfa__decode_kernel_end:
standalone__linear_kernel_rfa__decode_kernel_done:
  s_endpgm
standalone__linear_kernel_rfa__decode_kernel_codeend:
.section .rodata,"a"
.p2align 6
.amdhsa_kernel standalone__linear_kernel_rfa__decode_kernel
  .amdhsa_next_free_vgpr 168
  .amdhsa_next_free_sgpr 72
  .amdhsa_accum_offset 148
  .amdhsa_group_segment_fixed_size 0
  .amdhsa_kernarg_size 56
  .amdhsa_user_sgpr_count 2
  .amdhsa_user_sgpr_kernarg_segment_ptr 1
  .amdhsa_system_sgpr_workgroup_id_x 1
.end_amdhsa_kernel
```
